```python
import torch

def _softmax(x, axis=-1):
    return torch.softmax(x, dim=axis)
def _gelu(x):
    return torch.nn.functional.gelu(x, approximate="tanh")
def _silu(x):
    return torch.nn.functional.silu(x)
def _sigmoid(x):
    return torch.sigmoid(x)
def _layernorm(x, axis=-1, eps=1e-5):
    m = x.mean(dim=axis, keepdim=True)
    v = x.var(dim=axis, keepdim=True, unbiased=False)
    return (x - m) / torch.sqrt(v + eps)
def _scatter_add(tgt, idx, src, axis=0):
    return tgt.clone().index_add_(axis, idx, src)
def _segment_sum(src, seg, n):
    out = torch.zeros((n,) + src.shape[1:], dtype=src.dtype)
    return out.index_add_(0, seg, src)
def _pad(x, pw):
    flat = tuple(v for pair in reversed(pw) for v in pair)
    return torch.nn.functional.pad(x, flat)

kernel_name = 'standalone__linear_kernel_rfa__decode'

def setup_inputs():

    _w = (lambda a: (lambda t: t.to(torch.bfloat16) if t.is_floating_point() else t)(torch.as_tensor(a)))
    B, H, Sq, Sk, D, M = 2, 32, 1, 8192, 128, 8
    return {
        "q": _w((lambda *s: torch.randn(*s, dtype=torch.bfloat16) * 0.4)(B, H, Sq, D)),
        "k": _w((lambda *s: torch.randn(*s, dtype=torch.bfloat16) * 1.6)(B, H, Sk, D)),
        "v": _w((lambda *s: torch.randn(*s, dtype=torch.bfloat16) * 1.6)(B, H, Sk, D)),
        "omega": _w((lambda *s: torch.randn(*s, dtype=torch.bfloat16) * 1.6)(M, D)),
    }

def reference(q, k, v, omega):
    d = q.shape[-1]
    m = omega.shape[0]
    scale = float(d) ** -0.25
    qs = q * scale
    ks = k * scale
    q_proj = torch.einsum("bhsd,md->bhsm", qs, omega)
    k_proj = torch.einsum("bhsd,md->bhsm", ks, omega)
    q_sq = 0.5 * torch.einsum("bhsd,bhsd->bhs", qs, qs)[..., None]
    k_sq = 0.5 * torch.einsum("bhsd,bhsd->bhs", ks, ks)[..., None]
    inv_sqrt_m = float(m) ** -0.5
    phi_q = torch.exp(q_proj - q_sq) * inv_sqrt_m + 1e-6
    phi_k = torch.exp(k_proj - k_sq) * inv_sqrt_m + 1e-6
    kv = torch.einsum("bhsm,bhsd->bhmd", phi_k, v)
    z  = torch.einsum("bhsm->bhm", phi_k)
    num = torch.einsum("bhqm,bhmd->bhqd", phi_q, kv)
    den = torch.einsum("bhqm,bhm->bhq", phi_q, z)[..., None] + 1e-6
    return num / den
```

```asm
; @launch grid=(256,1,1) block=(320,1,1) lds=117824
.amdgcn_target "amdgcn-amd-amdhsa--gfx950"
.text
.globl standalone__linear_kernel_rfa__decode_kernel
.p2align 12
.p2align 8
.type standalone__linear_kernel_rfa__decode_kernel,@function
standalone__linear_kernel_rfa__decode_kernel:
s_cmp_ge_u32 s2, 256
s_cbranch_scc1 L_end
s_load_dwordx8 s[4:11], s[0:1], 0
v_lshrrev_b32 v121, 6, v0
v_and_b32 v0, 63, v0
v_and_b32 v120, 15, v0
v_readfirstlane_b32 s3, v121
v_lshrrev_b32 v121, 4, v0
s_lshr_b32 s37, s2, 1
s_and_b32 s19, s37, 3
s_xor_b32 s37, s37, s2
s_and_b32 s37, s37, 1
s_lshr_b32 s18, s2, 3
s_lshl1_add_u32 s18, s18, s37
v_xor_b32 v1, v121, v120
v_lshlrev_b32 v1, 4, v1
s_cmp_lg_u32 s3, 0
s_cbranch_scc1 L_cdisp
v_lshl_add_u32 v1, v121, 12, v1
s_and_b32 s57, s19, 1
s_lshl_b32 s57, s57, 14
s_lshr_b32 s38, s19, 1
s_lshl_b32 s38, s38, 18
s_or_b32 s57, s57, s38
s_mov_b32 s22, 2097152
s_mov_b32 s23, 0x20000
s_lshl_b32 s37, s18, 21
s_mov_b32 s58, 0
s_mov_b32 s56, 0
v_xor_b32 v2, 64, v1
v_xor_b32 v3, 0x80, v1
v_xor_b32 v4, 64, v3
s_mov_b32 s44, 0
s_movk_i32 s45, 0x1000
s_movk_i32 s46, 0x2000
s_movk_i32 s47, 0x3000
s_mov_b32 s32, s57
s_add_u32 s33, s57, 256
s_add_u32 s34, s57, 512
s_add_u32 s35, s57, 768
s_waitcnt lgkmcnt(0)
s_add_u32 s20, s6, s37
s_addc_u32 s21, s7, 0
L_lloop:
s_mov_b32 m0, s44
s_waitcnt vmcnt(19)
buffer_load_dwordx4 v1, s[20:23], s32 offen offset:0 nt lds
s_mov_b32 m0, s45
s_waitcnt vmcnt(20)
buffer_load_dwordx4 v1, s[20:23], s33 offen offset:0 nt lds
s_mov_b32 m0, s46
s_waitcnt vmcnt(19)
buffer_load_dwordx4 v1, s[20:23], s34 offen offset:0 nt lds
s_mov_b32 m0, s47
s_waitcnt vmcnt(20)
buffer_load_dwordx4 v1, s[20:23], s35 offen offset:0 nt lds
s_add_u32 s40, s32, 32768
s_add_u32 s52, s44, 0x4000
s_add_u32 s41, s33, 32768
s_add_u32 s53, s45, 0x4000
s_add_u32 s42, s34, 32768
s_add_u32 s54, s46, 0x4000
s_add_u32 s43, s35, 32768
s_add_u32 s55, s47, 0x4000
s_mov_b32 m0, s52
s_waitcnt vmcnt(19)
buffer_load_dwordx4 v1, s[20:23], s40 offen offset:0 nt lds
s_mov_b32 m0, s53
s_waitcnt vmcnt(20)
buffer_load_dwordx4 v1, s[20:23], s41 offen offset:0 nt lds
s_mov_b32 m0, s54
s_waitcnt vmcnt(19)
buffer_load_dwordx4 v1, s[20:23], s42 offen offset:0 nt lds
s_mov_b32 m0, s55
s_waitcnt vmcnt(20)
buffer_load_dwordx4 v1, s[20:23], s43 offen offset:0 nt lds
s_mov_b32 m0, s44
s_waitcnt vmcnt(19)
buffer_load_dwordx4 v2, s[20:23], s32 offen offset:1024 nt lds
s_mov_b32 m0, s45
s_waitcnt vmcnt(20)
buffer_load_dwordx4 v2, s[20:23], s33 offen offset:1024 nt lds
s_mov_b32 m0, s46
s_waitcnt vmcnt(19)
buffer_load_dwordx4 v2, s[20:23], s34 offen offset:1024 nt lds
s_mov_b32 m0, s47
s_waitcnt vmcnt(20)
buffer_load_dwordx4 v2, s[20:23], s35 offen offset:1024 nt lds
s_mov_b32 m0, s52
s_waitcnt vmcnt(19)
buffer_load_dwordx4 v2, s[20:23], s40 offen offset:1024 nt lds
s_mov_b32 m0, s53
s_waitcnt vmcnt(20)
buffer_load_dwordx4 v2, s[20:23], s41 offen offset:1024 nt lds
s_mov_b32 m0, s54
s_waitcnt vmcnt(19)
buffer_load_dwordx4 v2, s[20:23], s42 offen offset:1024 nt lds
s_mov_b32 m0, s55
s_waitcnt vmcnt(20)
buffer_load_dwordx4 v2, s[20:23], s43 offen offset:1024 nt lds
s_cmp_eq_u32 s58, 0
s_cbranch_scc1 L_lstart
L_lb:
s_mov_b32 m0, s44
s_waitcnt vmcnt(19)
buffer_load_dwordx4 v3, s[20:23], s32 offen offset:2048 nt lds
s_mov_b32 m0, s45
s_waitcnt vmcnt(20)
buffer_load_dwordx4 v3, s[20:23], s33 offen offset:2048 nt lds
s_mov_b32 m0, s46
s_waitcnt vmcnt(19)
buffer_load_dwordx4 v3, s[20:23], s34 offen offset:2048 nt lds
s_mov_b32 m0, s47
s_waitcnt vmcnt(20)
buffer_load_dwordx4 v3, s[20:23], s35 offen offset:2048 nt lds
s_mov_b32 m0, s52
s_waitcnt vmcnt(19)
buffer_load_dwordx4 v3, s[20:23], s40 offen offset:2048 nt lds
s_mov_b32 m0, s53
s_waitcnt vmcnt(20)
buffer_load_dwordx4 v3, s[20:23], s41 offen offset:2048 nt lds
s_mov_b32 m0, s54
s_waitcnt vmcnt(19)
buffer_load_dwordx4 v3, s[20:23], s42 offen offset:2048 nt lds
s_mov_b32 m0, s55
s_waitcnt vmcnt(20)
buffer_load_dwordx4 v3, s[20:23], s43 offen offset:2048 nt lds
s_mov_b32 m0, s44
s_waitcnt vmcnt(19)
buffer_load_dwordx4 v4, s[20:23], s32 offen offset:3072 nt lds
s_mov_b32 m0, s45
s_waitcnt vmcnt(20)
buffer_load_dwordx4 v4, s[20:23], s33 offen offset:3072 nt lds
s_mov_b32 m0, s46
s_waitcnt vmcnt(19)
buffer_load_dwordx4 v4, s[20:23], s34 offen offset:3072 nt lds
s_mov_b32 m0, s47
s_waitcnt vmcnt(20)
buffer_load_dwordx4 v4, s[20:23], s35 offen offset:3072 nt lds
s_mov_b32 m0, s52
s_waitcnt vmcnt(19)
buffer_load_dwordx4 v4, s[20:23], s40 offen offset:3072 nt lds
s_mov_b32 m0, s53
s_waitcnt vmcnt(20)
buffer_load_dwordx4 v4, s[20:23], s41 offen offset:3072 nt lds
s_mov_b32 m0, s54
s_waitcnt vmcnt(19)
buffer_load_dwordx4 v4, s[20:23], s42 offen offset:3072 nt lds
s_mov_b32 m0, s55
s_waitcnt vmcnt(20)
buffer_load_dwordx4 v4, s[20:23], s43 offen offset:3072 nt lds
L_ljoin:
s_or_b32 s56, s56, 0xffe4ffff
s_add_u32 s56, s56, 1
s_and_b32 s56, s56, 0x1b0000
s_or_b32 s32, s56, s57
s_add_u32 s44, s44, 0x8000
s_cmp_eq_u32 s44, 98304
s_cselect_b32 s44, 0, s44
s_add_u32 s33, s32, 256
s_add_u32 s45, s44, 4096
s_add_u32 s34, s32, 512
s_add_u32 s46, s44, 8192
s_add_u32 s35, s32, 768
s_add_u32 s47, s44, 12288
s_add_u32 s58, s58, 1
s_cmp_eq_u32 s58, 16
s_cbranch_scc1 L_lswitch
s_cmp_eq_u32 s58, 1
s_cbranch_scc0 L_lbar
s_waitcnt vmcnt(16)
L_lbar:
s_barrier
s_cmp_lt_u32 s58, 30
s_cbranch_scc1 L_lloop
s_branch L_lend
L_lfin:
s_waitcnt vmcnt(16)
s_barrier
s_waitcnt vmcnt(0)
s_barrier
s_endpgm
L_lswitch:
s_add_u32 s20, s8, s37
s_addc_u32 s21, s9, 0
v_lshlrev_b32 v1, 4, v120
v_lshl_add_u32 v1, v121, 12, v1
v_mov_b32 v2, v1
v_mov_b32 v3, v1
v_mov_b32 v4, v1
s_branch L_lbar
L_lstart:
s_mov_b32 s28, s10
s_mov_b32 s29, s11
s_movk_i32 s30, 2048
s_mov_b32 s31, 0x20000
s_mov_b32 m0, 98368
v_lshlrev_b32 v9, 4, v0
buffer_load_dwordx4 v9, s[28:31], 0 offen lds
buffer_load_dwordx4 v9, s[28:31], 0 offen offset:1024 lds
s_lshl_b32 s38, s18, 8
s_add_u32 s48, s4, s38
s_addc_u32 s49, s5, 0
s_movk_i32 s50, 256
s_mov_b32 s51, 0x20000
s_mov_b32 m0, 100416
s_setprio 3
buffer_load_dwordx4 v9, s[48:51], 0 offen lds
s_branch L_lb
L_cdisp:
s_cmp_eq_u32 s3, 1
s_cbranch_scc1 L_pad0
s_cmp_eq_u32 s3, 2
s_cbranch_scc1 L_pad1
s_cmp_eq_u32 s3, 3
s_cbranch_scc1 L_pad2
s_branch L_pad3
L_consumer:
s_load_dwordx4 s[12:15], s[0:1], 32
s_load_dwordx2 s[16:17], s[0:1], 48
s_sub_u32 s59, s3, 1
s_lshl_b32 s37, s59, 12
v_lshl_add_u32 v5, v120, 8, v1
v_add_u32 v5, s37, v5
v_lshlrev_b32 v9, 4, v0
v_add_u32 v123, s37, v9
v_add_u32 v125, 1024, v9
s_add_u32 s37, s37, 101440
v_lshl_add_u32 v126, v0, 2, s37
v_and_b32 v127, 12, v0
v_add_u32 v127, v127, v121
v_lshl_add_u32 v127, v127, 2, s37
v_and_b32 v56, 7, v0
v_lshlrev_b32 v56, 8, v56
v_lshlrev_b32 v57, 4, v121
v_add_u32 v56, v56, v57
v_add_u32 v64, 98368, v56
v_add_u32 v65, 100416, v57
s_mov_b32 s34, 0x3e9837f0
s_mov_b32 s35, s34
s_mov_b32 s36, 0xffff0000
s_mov_b32 s38, 0x3fb8aa3b
s_mov_b32 s39, s38
s_mov_b32 s42, 0x3eb504f3
s_mov_b32 s43, s42
s_mov_b32 s44, 0x358637bd
s_mov_b32 s45, s44
s_mov_b32 s32, 0
s_mov_b32 s41, 0
s_lshl_b32 s37, s18, 13
s_lshl_b32 s46, s18, 2
s_or_b32 s47, s19, s59
s_cmp_eq_u32 s47, 0
s_cselect_b32 s53, 2, -1
v_mov_b32 v124, 0
v_mov_b32 v88, -1
v_mov_b32 v89, -1
v_mov_b32 v90, -1
v_mov_b32 v91, -1
s_waitcnt lgkmcnt(0)
s_add_u32 s16, s16, s37
s_addc_u32 s17, s17, 0
s_add_u32 s54, s14, s46
s_addc_u32 s55, s15, 0
s_cmp_lg_u32 s59, 0
s_cbranch_scc1 L_noclr
s_lshl_b32 s37, s19, 10
v_add_u32 v58, s37, v125
global_store_dwordx4 v58, v[88:91], s[16:17] sc1
L_noclr:
v_and_b32 v58, 1, v0
v_lshlrev_b32 v58, 4, v58
v_mov_b32 v59, 0xffff
v_lshlrev_b32 v58, v58, v59
v_and_b32 v59, 2, v0
v_cmp_ne_u32 vcc, 0, v59
s_nop 1
v_cndmask_b32_e64 v10, v58, 0, vcc
v_cndmask_b32_e64 v11, 0, v58, vcc
v_lshlrev_b32 v58, 2, v121
v_sub_u32 v58, v120, v58
v_cmp_eq_u32 vcc, 0, v58
s_nop 1
v_cndmask_b32_e64 v12, 0, -1, vcc
v_cmp_eq_u32 vcc, 1, v58
s_nop 1
v_cndmask_b32_e64 v13, 0, -1, vcc
v_cmp_eq_u32 vcc, 2, v58
s_nop 1
v_cndmask_b32_e64 v14, 0, -1, vcc
v_cmp_eq_u32 vcc, 3, v58
s_nop 1
v_cndmask_b32_e64 v15, 0, -1, vcc
v_mov_b32 v16, 0
v_mov_b32 v40, 0
v_mov_b32 v41, 0
v_mov_b32 v42, 0
v_mov_b32 v43, 0
v_mov_b32 v44, 0
v_mov_b32 v45, 0
v_mov_b32 v46, 0
v_mov_b32 v47, 0
v_mov_b32 v48, 0
v_mov_b32 v49, 0
v_mov_b32 v50, 0
v_mov_b32 v51, 0
v_mov_b32 v52, 0
v_mov_b32 v53, 0
v_mov_b32 v54, 0
v_mov_b32 v55, 0
s_barrier
ds_read_b128 v[104:107], v64 offset:0
ds_read_b128 v[108:111], v64 offset:64
ds_read_b128 v[112:115], v64 offset:128
ds_read_b128 v[116:119], v64 offset:192
ds_read_b128 v[72:75], v65 offset:0
ds_read_b128 v[76:79], v65 offset:64
ds_read_b128 v[80:83], v65 offset:128
ds_read_b128 v[84:87], v65 offset:192
s_waitcnt lgkmcnt(3)
v_lshlrev_b32 v56, 16, v72
v_and_b32 v57, s36, v72
v_lshlrev_b32 v58, 16, v73
v_and_b32 v59, s36, v73
v_lshlrev_b32 v60, 16, v74
v_and_b32 v61, s36, v74
v_lshlrev_b32 v62, 16, v75
v_and_b32 v63, s36, v75
v_pk_mul_f32 v[56:57], v[56:57], s[34:35]
v_pk_mul_f32 v[58:59], v[58:59], s[34:35]
v_pk_mul_f32 v[60:61], v[60:61], s[34:35]
v_pk_mul_f32 v[62:63], v[62:63], s[34:35]
v_cvt_pk_bf16_f32 v72, v56, v57
v_cvt_pk_bf16_f32 v73, v58, v59
v_cvt_pk_bf16_f32 v74, v60, v61
v_cvt_pk_bf16_f32 v75, v62, v63
s_waitcnt lgkmcnt(2)
v_lshlrev_b32 v56, 16, v76
v_and_b32 v57, s36, v76
v_lshlrev_b32 v58, 16, v77
v_and_b32 v59, s36, v77
v_lshlrev_b32 v60, 16, v78
v_and_b32 v61, s36, v78
v_lshlrev_b32 v62, 16, v79
v_and_b32 v63, s36, v79
v_mfma_f32_16x16x32_bf16 v[24:27], v[104:107], v[72:75], 0
v_mfma_f32_16x16x32_bf16 v[32:35], v[72:75], v[72:75], 0
v_pk_mul_f32 v[56:57], v[56:57], s[34:35]
v_pk_mul_f32 v[58:59], v[58:59], s[34:35]
v_pk_mul_f32 v[60:61], v[60:61], s[34:35]
v_pk_mul_f32 v[62:63], v[62:63], s[34:35]
v_cvt_pk_bf16_f32 v76, v56, v57
v_cvt_pk_bf16_f32 v77, v58, v59
v_cvt_pk_bf16_f32 v78, v60, v61
v_cvt_pk_bf16_f32 v79, v62, v63
s_waitcnt lgkmcnt(1)
v_lshlrev_b32 v56, 16, v80
v_and_b32 v57, s36, v80
v_lshlrev_b32 v58, 16, v81
v_and_b32 v59, s36, v81
v_lshlrev_b32 v60, 16, v82
v_and_b32 v61, s36, v82
v_lshlrev_b32 v62, 16, v83
v_and_b32 v63, s36, v83
v_mfma_f32_16x16x32_bf16 v[24:27], v[108:111], v[76:79], v[24:27]
v_mfma_f32_16x16x32_bf16 v[32:35], v[76:79], v[76:79], v[32:35]
v_pk_mul_f32 v[56:57], v[56:57], s[34:35]
v_pk_mul_f32 v[58:59], v[58:59], s[34:35]
v_pk_mul_f32 v[60:61], v[60:61], s[34:35]
v_pk_mul_f32 v[62:63], v[62:63], s[34:35]
v_cvt_pk_bf16_f32 v80, v56, v57
v_cvt_pk_bf16_f32 v81, v58, v59
v_cvt_pk_bf16_f32 v82, v60, v61
v_cvt_pk_bf16_f32 v83, v62, v63
s_waitcnt lgkmcnt(0)
v_lshlrev_b32 v56, 16, v84
v_and_b32 v57, s36, v84
v_lshlrev_b32 v58, 16, v85
v_and_b32 v59, s36, v85
v_lshlrev_b32 v60, 16, v86
v_and_b32 v61, s36, v86
v_lshlrev_b32 v62, 16, v87
v_and_b32 v63, s36, v87
v_mfma_f32_16x16x32_bf16 v[24:27], v[112:115], v[80:83], v[24:27]
v_mfma_f32_16x16x32_bf16 v[32:35], v[80:83], v[80:83], v[32:35]
v_pk_mul_f32 v[56:57], v[56:57], s[34:35]
v_pk_mul_f32 v[58:59], v[58:59], s[34:35]
v_pk_mul_f32 v[60:61], v[60:61], s[34:35]
v_pk_mul_f32 v[62:63], v[62:63], s[34:35]
v_cvt_pk_bf16_f32 v84, v56, v57
v_cvt_pk_bf16_f32 v85, v58, v59
v_cvt_pk_bf16_f32 v86, v60, v61
v_cvt_pk_bf16_f32 v87, v62, v63
s_nop 1
v_mfma_f32_16x16x32_bf16 v[24:27], v[116:119], v[84:87], v[24:27]
v_mfma_f32_16x16x32_bf16 v[32:35], v[84:87], v[84:87], v[32:35]
s_nop 7
v_cvt_pk_bf16_f32 v62, v32, v32
v_cvt_pk_bf16_f32 v60, v24, v25
v_cvt_pk_bf16_f32 v61, v26, v27
v_and_b32 v62, s36, v62
v_lshlrev_b32 v56, 16, v60
v_and_b32 v57, s36, v60
v_lshlrev_b32 v58, 16, v61
v_and_b32 v59, s36, v61
v_fma_f32 v56, v62, -0.5, v56
v_fma_f32 v57, v62, -0.5, v57
v_fma_f32 v58, v62, -0.5, v58
v_fma_f32 v59, v62, -0.5, v59
v_cvt_pk_bf16_f32 v60, v56, v57
v_cvt_pk_bf16_f32 v61, v58, v59
v_lshlrev_b32 v56, 16, v60
v_and_b32 v57, s36, v60
v_lshlrev_b32 v58, 16, v61
v_and_b32 v59, s36, v61
v_pk_mul_f32 v[56:57], v[56:57], s[38:39]
v_pk_mul_f32 v[58:59], v[58:59], s[38:39]
v_exp_f32 v56, v56
v_exp_f32 v57, v57
v_exp_f32 v58, v58
v_exp_f32 v59, v59
v_cvt_pk_bf16_f32 v60, v56, v57
v_cvt_pk_bf16_f32 v61, v58, v59
v_lshlrev_b32 v56, 16, v60
v_and_b32 v57, s36, v60
v_lshlrev_b32 v58, 16, v61
v_and_b32 v59, s36, v61
v_pk_mul_f32 v[56:57], v[56:57], s[42:43]
v_pk_mul_f32 v[58:59], v[58:59], s[42:43]
v_cvt_pk_bf16_f32 v60, v56, v57
v_cvt_pk_bf16_f32 v61, v58, v59
v_lshlrev_b32 v56, 16, v60
v_and_b32 v57, s36, v60
v_lshlrev_b32 v58, 16, v61
v_and_b32 v59, s36, v61
v_pk_add_f32 v[56:57], v[56:57], s[44:45]
v_pk_add_f32 v[58:59], v[58:59], s[44:45]
v_cvt_pk_bf16_f32 v17, v56, v57
v_cvt_pk_bf16_f32 v18, v58, v59
s_branch L_kloop
L_lend:
s_mov_b32 m0, s44
s_waitcnt vmcnt(31)
buffer_load_dwordx4 v1, s[20:23], s32 offen offset:0 nt lds
s_mov_b32 m0, s45
s_waitcnt vmcnt(31)
buffer_load_dwordx4 v1, s[20:23], s33 offen offset:0 nt lds
s_mov_b32 m0, s46
s_waitcnt vmcnt(31)
buffer_load_dwordx4 v1, s[20:23], s34 offen offset:0 nt lds
s_mov_b32 m0, s47
s_waitcnt vmcnt(31)
buffer_load_dwordx4 v1, s[20:23], s35 offen offset:0 nt lds
s_add_u32 s40, s32, 32768
s_add_u32 s52, s44, 0x4000
s_add_u32 s41, s33, 32768
s_add_u32 s53, s45, 0x4000
s_add_u32 s42, s34, 32768
s_add_u32 s54, s46, 0x4000
s_add_u32 s43, s35, 32768
s_add_u32 s55, s47, 0x4000
s_mov_b32 m0, s52
s_waitcnt vmcnt(31)
buffer_load_dwordx4 v1, s[20:23], s40 offen offset:0 nt lds
s_mov_b32 m0, s53
s_waitcnt vmcnt(31)
buffer_load_dwordx4 v1, s[20:23], s41 offen offset:0 nt lds
s_mov_b32 m0, s54
s_waitcnt vmcnt(31)
buffer_load_dwordx4 v1, s[20:23], s42 offen offset:0 nt lds
s_mov_b32 m0, s55
s_waitcnt vmcnt(31)
buffer_load_dwordx4 v1, s[20:23], s43 offen offset:0 nt lds
s_mov_b32 m0, s44
s_waitcnt vmcnt(31)
buffer_load_dwordx4 v2, s[20:23], s32 offen offset:1024 nt lds
s_mov_b32 m0, s45
s_waitcnt vmcnt(31)
buffer_load_dwordx4 v2, s[20:23], s33 offen offset:1024 nt lds
s_mov_b32 m0, s46
s_waitcnt vmcnt(31)
buffer_load_dwordx4 v2, s[20:23], s34 offen offset:1024 nt lds
s_mov_b32 m0, s47
s_waitcnt vmcnt(31)
buffer_load_dwordx4 v2, s[20:23], s35 offen offset:1024 nt lds
s_mov_b32 m0, s52
s_waitcnt vmcnt(31)
buffer_load_dwordx4 v2, s[20:23], s40 offen offset:1024 nt lds
s_mov_b32 m0, s53
s_waitcnt vmcnt(31)
buffer_load_dwordx4 v2, s[20:23], s41 offen offset:1024 nt lds
s_mov_b32 m0, s54
s_waitcnt vmcnt(31)
buffer_load_dwordx4 v2, s[20:23], s42 offen offset:1024 nt lds
s_mov_b32 m0, s55
s_waitcnt vmcnt(31)
buffer_load_dwordx4 v2, s[20:23], s43 offen offset:1024 nt lds
s_mov_b32 m0, s44
s_waitcnt vmcnt(31)
buffer_load_dwordx4 v3, s[20:23], s32 offen offset:2048 nt lds
s_mov_b32 m0, s45
s_waitcnt vmcnt(31)
buffer_load_dwordx4 v3, s[20:23], s33 offen offset:2048 nt lds
s_mov_b32 m0, s46
s_waitcnt vmcnt(31)
buffer_load_dwordx4 v3, s[20:23], s34 offen offset:2048 nt lds
s_mov_b32 m0, s47
s_waitcnt vmcnt(31)
buffer_load_dwordx4 v3, s[20:23], s35 offen offset:2048 nt lds
s_mov_b32 m0, s52
s_waitcnt vmcnt(31)
buffer_load_dwordx4 v3, s[20:23], s40 offen offset:2048 nt lds
s_mov_b32 m0, s53
s_waitcnt vmcnt(31)
buffer_load_dwordx4 v3, s[20:23], s41 offen offset:2048 nt lds
s_mov_b32 m0, s54
s_waitcnt vmcnt(31)
buffer_load_dwordx4 v3, s[20:23], s42 offen offset:2048 nt lds
s_mov_b32 m0, s55
s_waitcnt vmcnt(31)
buffer_load_dwordx4 v3, s[20:23], s43 offen offset:2048 nt lds
s_mov_b32 m0, s44
s_waitcnt vmcnt(31)
buffer_load_dwordx4 v4, s[20:23], s32 offen offset:3072 nt lds
s_mov_b32 m0, s45
s_waitcnt vmcnt(31)
buffer_load_dwordx4 v4, s[20:23], s33 offen offset:3072 nt lds
s_mov_b32 m0, s46
s_waitcnt vmcnt(31)
buffer_load_dwordx4 v4, s[20:23], s34 offen offset:3072 nt lds
s_mov_b32 m0, s47
s_waitcnt vmcnt(31)
buffer_load_dwordx4 v4, s[20:23], s35 offen offset:3072 nt lds
s_mov_b32 m0, s52
s_waitcnt vmcnt(31)
buffer_load_dwordx4 v4, s[20:23], s40 offen offset:3072 nt lds
s_mov_b32 m0, s53
s_waitcnt vmcnt(31)
buffer_load_dwordx4 v4, s[20:23], s41 offen offset:3072 nt lds
s_mov_b32 m0, s54
s_waitcnt vmcnt(31)
buffer_load_dwordx4 v4, s[20:23], s42 offen offset:3072 nt lds
s_mov_b32 m0, s55
s_waitcnt vmcnt(31)
buffer_load_dwordx4 v4, s[20:23], s43 offen offset:3072 nt lds
s_or_b32 s56, s56, 0xffe4ffff
s_add_u32 s56, s56, 1
s_and_b32 s56, s56, 0x1b0000
s_or_b32 s32, s56, s57
s_add_u32 s44, s44, 0x8000
s_cmp_eq_u32 s44, 98304
s_cselect_b32 s44, 0, s44
s_add_u32 s33, s32, 256
s_add_u32 s45, s44, 4096
s_add_u32 s34, s32, 512
s_add_u32 s46, s44, 8192
s_add_u32 s35, s32, 768
s_add_u32 s47, s44, 12288
s_add_u32 s58, s58, 1
s_waitcnt vmcnt(32)
s_barrier
s_cmp_lt_u32 s58, 32
s_cbranch_scc1 L_lend
s_branch L_lfin
.p2align 12
L_pad0:
s_branch L_consumer

L_kloop:
v_add_u32 v6, s32, v5
v_xor_b32 v7, 64, v6
v_xor_b32 v8, 0x80, v6
v_xor_b32 v19, 64, v8
s_add_u32 s32, s32, 0x8000
s_cmp_eq_u32 s32, 98304
s_cselect_b32 s32, 0, s32
s_barrier
ds_read_b128 v[72:75], v6
ds_read_b128 v[76:79], v7
ds_read_b128 v[80:83], v8
ds_read_b128 v[84:87], v19
ds_read_b128 v[88:91], v6 offset:16384
ds_read_b128 v[92:95], v7 offset:16384
ds_read_b128 v[96:99], v8 offset:16384
ds_read_b128 v[100:103], v19 offset:16384
s_waitcnt lgkmcnt(7)
v_lshlrev_b32 v56, 16, v72
v_and_b32 v57, s36, v72
v_lshlrev_b32 v58, 16, v73
v_and_b32 v59, s36, v73
v_lshlrev_b32 v60, 16, v74
v_and_b32 v61, s36, v74
v_lshlrev_b32 v62, 16, v75
v_and_b32 v63, s36, v75
v_pk_mul_f32 v[56:57], v[56:57], s[34:35]
v_pk_mul_f32 v[58:59], v[58:59], s[34:35]
v_pk_mul_f32 v[60:61], v[60:61], s[34:35]
v_pk_mul_f32 v[62:63], v[62:63], s[34:35]
v_cvt_pk_bf16_f32 v72, v56, v57
v_cvt_pk_bf16_f32 v73, v58, v59
v_cvt_pk_bf16_f32 v74, v60, v61
v_cvt_pk_bf16_f32 v75, v62, v63
s_waitcnt lgkmcnt(6)
v_lshlrev_b32 v56, 16, v76
v_and_b32 v57, s36, v76
v_lshlrev_b32 v58, 16, v77
v_and_b32 v59, s36, v77
v_lshlrev_b32 v60, 16, v78
v_and_b32 v61, s36, v78
v_lshlrev_b32 v62, 16, v79
v_and_b32 v63, s36, v79
v_mfma_f32_16x16x32_bf16 v[24:27], v[104:107], v[72:75], 0
v_mfma_f32_16x16x32_bf16 v[32:35], v[72:75], v[72:75], 0
v_pk_mul_f32 v[56:57], v[56:57], s[34:35]
v_pk_mul_f32 v[58:59], v[58:59], s[34:35]
v_pk_mul_f32 v[60:61], v[60:61], s[34:35]
v_pk_mul_f32 v[62:63], v[62:63], s[34:35]
v_cvt_pk_bf16_f32 v76, v56, v57
v_cvt_pk_bf16_f32 v77, v58, v59
v_cvt_pk_bf16_f32 v78, v60, v61
v_cvt_pk_bf16_f32 v79, v62, v63
s_waitcnt lgkmcnt(5)
v_lshlrev_b32 v56, 16, v80
v_and_b32 v57, s36, v80
v_lshlrev_b32 v58, 16, v81
v_and_b32 v59, s36, v81
v_lshlrev_b32 v60, 16, v82
v_and_b32 v61, s36, v82
v_lshlrev_b32 v62, 16, v83
v_and_b32 v63, s36, v83
v_mfma_f32_16x16x32_bf16 v[24:27], v[108:111], v[76:79], v[24:27]
v_mfma_f32_16x16x32_bf16 v[32:35], v[76:79], v[76:79], v[32:35]
v_pk_mul_f32 v[56:57], v[56:57], s[34:35]
v_pk_mul_f32 v[58:59], v[58:59], s[34:35]
v_pk_mul_f32 v[60:61], v[60:61], s[34:35]
v_pk_mul_f32 v[62:63], v[62:63], s[34:35]
v_cvt_pk_bf16_f32 v80, v56, v57
v_cvt_pk_bf16_f32 v81, v58, v59
v_cvt_pk_bf16_f32 v82, v60, v61
v_cvt_pk_bf16_f32 v83, v62, v63
s_waitcnt lgkmcnt(4)
v_lshlrev_b32 v56, 16, v84
v_and_b32 v57, s36, v84
v_lshlrev_b32 v58, 16, v85
v_and_b32 v59, s36, v85
v_lshlrev_b32 v60, 16, v86
v_and_b32 v61, s36, v86
v_lshlrev_b32 v62, 16, v87
v_and_b32 v63, s36, v87
v_mfma_f32_16x16x32_bf16 v[24:27], v[112:115], v[80:83], v[24:27]
v_mfma_f32_16x16x32_bf16 v[32:35], v[80:83], v[80:83], v[32:35]
v_pk_mul_f32 v[56:57], v[56:57], s[34:35]
v_pk_mul_f32 v[58:59], v[58:59], s[34:35]
v_pk_mul_f32 v[60:61], v[60:61], s[34:35]
v_pk_mul_f32 v[62:63], v[62:63], s[34:35]
v_cvt_pk_bf16_f32 v84, v56, v57
v_cvt_pk_bf16_f32 v85, v58, v59
v_cvt_pk_bf16_f32 v86, v60, v61
v_cvt_pk_bf16_f32 v87, v62, v63
s_waitcnt lgkmcnt(3)
v_lshlrev_b32 v56, 16, v88
v_and_b32 v57, s36, v88
v_lshlrev_b32 v58, 16, v89
v_and_b32 v59, s36, v89
v_lshlrev_b32 v60, 16, v90
v_and_b32 v61, s36, v90
v_lshlrev_b32 v62, 16, v91
v_and_b32 v63, s36, v91
v_mfma_f32_16x16x32_bf16 v[24:27], v[116:119], v[84:87], v[24:27]
v_mfma_f32_16x16x32_bf16 v[32:35], v[84:87], v[84:87], v[32:35]
v_pk_mul_f32 v[56:57], v[56:57], s[34:35]
v_pk_mul_f32 v[58:59], v[58:59], s[34:35]
v_pk_mul_f32 v[60:61], v[60:61], s[34:35]
v_pk_mul_f32 v[62:63], v[62:63], s[34:35]
v_cvt_pk_bf16_f32 v88, v56, v57
v_cvt_pk_bf16_f32 v89, v58, v59
v_cvt_pk_bf16_f32 v90, v60, v61
v_cvt_pk_bf16_f32 v91, v62, v63
s_branch L_skip1
L_pad1:
s_branch L_consumer
L_skip1:
s_waitcnt lgkmcnt(2)
v_lshlrev_b32 v56, 16, v92
v_and_b32 v57, s36, v92
v_lshlrev_b32 v58, 16, v93
v_and_b32 v59, s36, v93
v_lshlrev_b32 v60, 16, v94
v_and_b32 v61, s36, v94
v_lshlrev_b32 v62, 16, v95
v_and_b32 v63, s36, v95
v_mfma_f32_16x16x32_bf16 v[28:31], v[104:107], v[88:91], 0
v_mfma_f32_16x16x32_bf16 v[36:39], v[88:91], v[88:91], 0
v_pk_mul_f32 v[56:57], v[56:57], s[34:35]
v_pk_mul_f32 v[58:59], v[58:59], s[34:35]
v_pk_mul_f32 v[60:61], v[60:61], s[34:35]
v_pk_mul_f32 v[62:63], v[62:63], s[34:35]
v_cvt_pk_bf16_f32 v92, v56, v57
v_cvt_pk_bf16_f32 v93, v58, v59
v_cvt_pk_bf16_f32 v94, v60, v61
v_cvt_pk_bf16_f32 v95, v62, v63
s_waitcnt lgkmcnt(1)
v_lshlrev_b32 v56, 16, v96
v_and_b32 v57, s36, v96
v_lshlrev_b32 v58, 16, v97
v_and_b32 v59, s36, v97
v_lshlrev_b32 v60, 16, v98
v_and_b32 v61, s36, v98
v_lshlrev_b32 v62, 16, v99
v_and_b32 v63, s36, v99
v_mfma_f32_16x16x32_bf16 v[28:31], v[108:111], v[92:95], v[28:31]
v_mfma_f32_16x16x32_bf16 v[36:39], v[92:95], v[92:95], v[36:39]
v_pk_mul_f32 v[56:57], v[56:57], s[34:35]
v_pk_mul_f32 v[58:59], v[58:59], s[34:35]
v_pk_mul_f32 v[60:61], v[60:61], s[34:35]
v_pk_mul_f32 v[62:63], v[62:63], s[34:35]
v_cvt_pk_bf16_f32 v96, v56, v57
v_cvt_pk_bf16_f32 v97, v58, v59
v_cvt_pk_bf16_f32 v98, v60, v61
v_cvt_pk_bf16_f32 v99, v62, v63
s_waitcnt lgkmcnt(0)
v_lshlrev_b32 v56, 16, v100
v_and_b32 v57, s36, v100
v_lshlrev_b32 v58, 16, v101
v_and_b32 v59, s36, v101
v_lshlrev_b32 v60, 16, v102
v_and_b32 v61, s36, v102
v_lshlrev_b32 v62, 16, v103
v_and_b32 v63, s36, v103
v_mfma_f32_16x16x32_bf16 v[28:31], v[112:115], v[96:99], v[28:31]
v_mfma_f32_16x16x32_bf16 v[36:39], v[96:99], v[96:99], v[36:39]
v_pk_mul_f32 v[56:57], v[56:57], s[34:35]
v_pk_mul_f32 v[58:59], v[58:59], s[34:35]
v_pk_mul_f32 v[60:61], v[60:61], s[34:35]
v_pk_mul_f32 v[62:63], v[62:63], s[34:35]
v_cvt_pk_bf16_f32 v100, v56, v57
v_cvt_pk_bf16_f32 v101, v58, v59
v_cvt_pk_bf16_f32 v102, v60, v61
v_cvt_pk_bf16_f32 v103, v62, v63
s_nop 1
v_mfma_f32_16x16x32_bf16 v[28:31], v[116:119], v[100:103], v[28:31]
v_mfma_f32_16x16x32_bf16 v[36:39], v[100:103], v[100:103], v[36:39]
v_and_b32 v64, v32, v12
v_and_or_b32 v64, v33, v13, v64
v_and_or_b32 v64, v34, v14, v64
v_and_or_b32 v64, v35, v15, v64
s_nop 3
v_and_b32 v65, v36, v12
v_and_or_b32 v65, v37, v13, v65
v_and_or_b32 v65, v38, v14, v65
v_and_or_b32 v65, v39, v15, v65
v_permlane32_swap_b32 v24, v28
v_permlane32_swap_b32 v25, v29
v_permlane32_swap_b32 v64, v65
v_or_b32 v64, v64, v65
v_mov_b32 v65, v64
v_permlane32_swap_b32 v26, v30
v_permlane32_swap_b32 v27, v31
v_permlane16_swap_b32 v64, v65
v_or_b32 v64, v64, v65
v_cvt_pk_bf16_f32 v62, v64, v64
v_cvt_pk_bf16_f32 v60, v24, v25
v_cvt_pk_bf16_f32 v61, v26, v27
v_and_b32 v62, s36, v62
v_lshlrev_b32 v56, 16, v60
v_and_b32 v57, s36, v60
v_lshlrev_b32 v58, 16, v61
v_and_b32 v59, s36, v61
v_fma_f32 v56, v62, -0.5, v56
v_fma_f32 v57, v62, -0.5, v57
v_fma_f32 v58, v62, -0.5, v58
v_fma_f32 v59, v62, -0.5, v59
v_cvt_pk_bf16_f32 v60, v56, v57
v_cvt_pk_bf16_f32 v61, v58, v59
v_lshlrev_b32 v56, 16, v60
v_and_b32 v57, s36, v60
v_lshlrev_b32 v58, 16, v61
v_and_b32 v59, s36, v61
v_pk_mul_f32 v[56:57], v[56:57], s[38:39]
v_pk_mul_f32 v[58:59], v[58:59], s[38:39]
v_exp_f32 v56, v56
v_exp_f32 v57, v57
v_exp_f32 v58, v58
v_exp_f32 v59, v59
v_cvt_pk_bf16_f32 v60, v56, v57
v_cvt_pk_bf16_f32 v61, v58, v59
v_lshlrev_b32 v56, 16, v60
v_and_b32 v57, s36, v60
v_lshlrev_b32 v58, 16, v61
v_and_b32 v59, s36, v61
v_pk_mul_f32 v[56:57], v[56:57], s[42:43]
v_pk_mul_f32 v[58:59], v[58:59], s[42:43]
v_cvt_pk_bf16_f32 v60, v56, v57
v_cvt_pk_bf16_f32 v61, v58, v59
v_lshlrev_b32 v56, 16, v60
v_and_b32 v57, s36, v60
v_lshlrev_b32 v58, 16, v61
v_and_b32 v59, s36, v61
v_pk_add_f32 v[56:57], v[56:57], s[44:45]
v_pk_add_f32 v[58:59], v[58:59], s[44:45]
v_cvt_pk_bf16_f32 v66, v56, v57
v_cvt_pk_bf16_f32 v67, v58, v59
v_dot2_f32_bf16 v68, v66, v17, 0
v_dot2_f32_bf16 v68, v67, v18, v68
s_nop 1
L_flagset:
s_add_u32 s41, s41, 1
v_mov_b32 v69, v68
s_nop 1
v_permlane16_swap_b32 v68, v69
v_add_f32 v68, v68, v69
v_cvt_pk_bf16_f32 v68, v68, v68
ds_write_b32 v126, v68
v_and_b32 v69, s36, v68
v_add_f32 v16, v16, v69
v_add_u32 v126, 256, v126
s_cmp_lt_u32 s41, 16
s_cbranch_scc1 L_kloop
v_add_f32_dpp v16, v16, v16 row_ror:8 row_mask:0xf bank_mask:0xf
s_nop 1
v_add_f32_dpp v16, v16, v16 row_ror:4 row_mask:0xf bank_mask:0xf
s_nop 1
v_add_f32_dpp v16, v16, v16 row_ror:2 row_mask:0xf bank_mask:0xf
s_nop 1
v_add_f32_dpp v16, v16, v16 row_ror:1 row_mask:0xf bank_mask:0xf
s_nop 1
s_lshl_b32 s37, s59, 4
s_add_u32 s37, s37, 98304
v_lshl_add_u32 v56, v121, 2, s37
ds_write_b32 v56, v16
s_branch L_skip2
L_pad2:
s_branch L_consumer
L_skip2:
L_vloop:
ds_read_b32 v56, v127
ds_read_b32 v57, v127 offset:128
v_add_u32 v122, s32, v123
v_add_u32 v127, 256, v127
s_add_u32 s32, s32, 0x8000
s_cmp_eq_u32 s32, 98304
s_cselect_b32 s32, 0, s32
s_waitcnt lgkmcnt(0)
v_and_b32 v20, v56, v10
v_and_b32 v21, v56, v11
v_and_b32 v22, v57, v10
v_and_b32 v23, v57, v11
s_barrier
ds_read_b128 v[72:75], v122 offset:0
ds_read_b128 v[76:79], v122 offset:1024
ds_read_b128 v[80:83], v122 offset:2048
ds_read_b128 v[84:87], v122 offset:3072
ds_read_b128 v[88:91], v122 offset:16384
ds_read_b128 v[92:95], v122 offset:17408
ds_read_b128 v[96:99], v122 offset:18432
ds_read_b128 v[100:103], v122 offset:19456
s_waitcnt lgkmcnt(7)
v_mfma_f32_4x4x4_16b_bf16 v[40:43], v[20:21], v[72:73], v[40:43] cbsz:2 abid:0
v_mfma_f32_4x4x4_16b_bf16 v[44:47], v[20:21], v[74:75], v[44:47] cbsz:2 abid:0
s_waitcnt lgkmcnt(6)
v_mfma_f32_4x4x4_16b_bf16 v[48:51], v[20:21], v[76:77], v[48:51] cbsz:2 abid:1
v_mfma_f32_4x4x4_16b_bf16 v[52:55], v[20:21], v[78:79], v[52:55] cbsz:2 abid:1
s_waitcnt lgkmcnt(5)
v_mfma_f32_4x4x4_16b_bf16 v[40:43], v[20:21], v[80:81], v[40:43] cbsz:2 abid:2
v_mfma_f32_4x4x4_16b_bf16 v[44:47], v[20:21], v[82:83], v[44:47] cbsz:2 abid:2
s_waitcnt lgkmcnt(4)
v_mfma_f32_4x4x4_16b_bf16 v[48:51], v[20:21], v[84:85], v[48:51] cbsz:2 abid:3
v_mfma_f32_4x4x4_16b_bf16 v[52:55], v[20:21], v[86:87], v[52:55] cbsz:2 abid:3
s_waitcnt lgkmcnt(3)
v_mfma_f32_4x4x4_16b_bf16 v[40:43], v[22:23], v[88:89], v[40:43] cbsz:2 abid:0
v_mfma_f32_4x4x4_16b_bf16 v[44:47], v[22:23], v[90:91], v[44:47] cbsz:2 abid:0
s_waitcnt lgkmcnt(2)
v_mfma_f32_4x4x4_16b_bf16 v[48:51], v[22:23], v[92:93], v[48:51] cbsz:2 abid:1
v_mfma_f32_4x4x4_16b_bf16 v[52:55], v[22:23], v[94:95], v[52:55] cbsz:2 abid:1
s_waitcnt lgkmcnt(1)
v_mfma_f32_4x4x4_16b_bf16 v[40:43], v[22:23], v[96:97], v[40:43] cbsz:2 abid:2
v_mfma_f32_4x4x4_16b_bf16 v[44:47], v[22:23], v[98:99], v[44:47] cbsz:2 abid:2
s_waitcnt lgkmcnt(0)
v_mfma_f32_4x4x4_16b_bf16 v[48:51], v[22:23], v[100:101], v[48:51] cbsz:2 abid:3
v_mfma_f32_4x4x4_16b_bf16 v[52:55], v[22:23], v[102:103], v[52:55] cbsz:2 abid:3
s_add_u32 s41, s41, 1
s_cmp_lt_u32 s41, 31
s_cbranch_scc1 L_vloop
s_branch L_vtail
L_pad3:
s_branch L_consumer

L_vtail:
ds_read_b32 v56, v127
ds_read_b32 v57, v127 offset:128
v_add_u32 v122, s32, v123
v_add_u32 v127, 256, v127
s_add_u32 s32, s32, 0x8000
s_cmp_eq_u32 s32, 98304
s_cselect_b32 s32, 0, s32
s_waitcnt lgkmcnt(0)
v_and_b32 v20, v56, v10
v_and_b32 v21, v56, v11
v_and_b32 v22, v57, v10
v_and_b32 v23, v57, v11
v_mov_b32 v70, 0
v_mov_b32 v71, 1
s_cmp_lg_u32 s59, 0
s_cbranch_scc1 L_flagok
v_mov_b32 v56, 98304
ds_read_b128 v[104:107], v56 offset:0
ds_read_b128 v[108:111], v56 offset:16
ds_read_b128 v[112:115], v56 offset:32
ds_read_b128 v[116:119], v56 offset:48
s_lshl_b32 s37, s18, 8
s_add_u32 s12, s12, s37
s_addc_u32 s13, s13, 0
s_lshl_b32 s37, s19, 10
v_add_u32 v58, s37, v125
v_lshlrev_b32 v59, 2, v0
v_lshlrev_b32 v60, 3, v0
s_waitcnt lgkmcnt(0)
v_pk_add_f32 v[104:105], v[104:105], v[106:107]
v_pk_add_f32 v[108:109], v[108:109], v[110:111]
v_pk_add_f32 v[112:113], v[112:113], v[114:115]
v_pk_add_f32 v[116:117], v[116:117], v[118:119]
v_pk_add_f32 v[104:105], v[104:105], v[108:109]
v_pk_add_f32 v[112:113], v[112:113], v[116:117]
v_pk_add_f32 v[104:105], v[104:105], v[112:113]
v_add_f32 v26, v104, v105
v_mul_f32 v26, 0.5, v26
v_min_u32 v26, -2, v26
v_mov_b32 v27, 0
L_flagok:
s_waitcnt vmcnt(0)
s_barrier
ds_read_b128 v[72:75], v122 offset:0
ds_read_b128 v[88:91], v122 offset:16384
ds_read_b128 v[76:79], v122 offset:1024
ds_read_b128 v[92:95], v122 offset:17408
s_lshl_b32 s37, s59, 10
v_lshlrev_b32 v56, 5, v120
v_lshl_add_u32 v56, v121, 3, v56
v_add_u32 v56, s37, v56
s_waitcnt lgkmcnt(3)
v_mfma_f32_4x4x4_16b_bf16 v[40:43], v[20:21], v[72:73], v[40:43] cbsz:2 abid:0
v_mfma_f32_4x4x4_16b_bf16 v[44:47], v[20:21], v[74:75], v[44:47] cbsz:2 abid:0
s_waitcnt lgkmcnt(2)
v_mfma_f32_4x4x4_16b_bf16 v[48:51], v[22:23], v[88:89], v[48:51] cbsz:2 abid:0
v_mfma_f32_4x4x4_16b_bf16 v[52:55], v[22:23], v[90:91], v[52:55] cbsz:2 abid:0
s_waitcnt lgkmcnt(1)
v_mfma_f32_4x4x4_16b_bf16 v[40:43], v[20:21], v[76:77], v[40:43] cbsz:2 abid:1
v_mfma_f32_4x4x4_16b_bf16 v[44:47], v[20:21], v[78:79], v[44:47] cbsz:2 abid:1
s_waitcnt lgkmcnt(0)
v_mfma_f32_4x4x4_16b_bf16 v[48:51], v[22:23], v[92:93], v[48:51] cbsz:2 abid:1
v_mfma_f32_4x4x4_16b_bf16 v[52:55], v[22:23], v[94:95], v[52:55] cbsz:2 abid:1
s_nop 4
v_add_f32 v40, v40, v48
v_add_f32 v41, v41, v49
v_add_f32 v42, v42, v50
v_add_f32 v43, v43, v51
v_add_f32 v44, v44, v52
v_add_f32 v45, v45, v53
v_add_f32 v46, v46, v54
v_add_f32 v47, v47, v55
s_barrier
ds_read_b128 v[80:83], v122 offset:2048
ds_read_b128 v[96:99], v122 offset:18432
ds_read_b128 v[84:87], v122 offset:3072
ds_read_b128 v[100:103], v122 offset:19456
s_cmp_lg_u32 s59, 0
s_cbranch_scc1 L_nopre
s_mov_b64 exec, 1
global_atomic_add v124, v70, v71, s[54:55] sc0
s_mov_b64 exec, -1
global_load_dwordx4 v[104:107], v125, s[16:17] offset:0 sc1
global_load_dwordx4 v[108:111], v125, s[16:17] offset:1024 sc1
global_load_dwordx4 v[112:115], v125, s[16:17] offset:2048 sc1
global_load_dwordx4 v[116:119], v125, s[16:17] offset:3072 sc1
L_nopre:
s_waitcnt lgkmcnt(3)
v_mfma_f32_4x4x4_16b_bf16 v[40:43], v[20:21], v[80:81], v[40:43] cbsz:2 abid:2
v_mfma_f32_4x4x4_16b_bf16 v[44:47], v[20:21], v[82:83], v[44:47] cbsz:2 abid:2
s_waitcnt lgkmcnt(2)
v_mfma_f32_4x4x4_16b_bf16 v[40:43], v[22:23], v[96:97], v[40:43] cbsz:2 abid:2
v_mfma_f32_4x4x4_16b_bf16 v[44:47], v[22:23], v[98:99], v[44:47] cbsz:2 abid:2
s_waitcnt lgkmcnt(1)
v_mfma_f32_4x4x4_16b_bf16 v[40:43], v[20:21], v[84:85], v[40:43] cbsz:2 abid:3
v_mfma_f32_4x4x4_16b_bf16 v[44:47], v[20:21], v[86:87], v[44:47] cbsz:2 abid:3
s_waitcnt lgkmcnt(0)
v_mfma_f32_4x4x4_16b_bf16 v[40:43], v[22:23], v[100:101], v[40:43] cbsz:2 abid:3
v_mfma_f32_4x4x4_16b_bf16 v[44:47], v[22:23], v[102:103], v[44:47] cbsz:2 abid:3
s_nop 4
v_permlane32_swap_b32 v40, v44
v_permlane32_swap_b32 v41, v45
v_permlane32_swap_b32 v42, v46
v_permlane32_swap_b32 v43, v47
v_add_f32 v40, v40, v44
v_add_f32 v41, v41, v45
v_add_f32 v42, v42, v46
v_add_f32 v43, v43, v47
s_nop 0
v_permlane16_swap_b32 v40, v42
v_permlane16_swap_b32 v41, v43
v_add_f32 v40, v40, v42
v_add_f32 v41, v41, v43
ds_write_b64 v56, v[40:41]
s_waitcnt lgkmcnt(0)
s_barrier
s_cmp_lg_u32 s59, 0
s_cbranch_scc1 L_fin
ds_read_b64 v[76:77], v60 offset:0
ds_read_b64 v[78:79], v60 offset:1024
ds_read_b64 v[80:81], v60 offset:2048
ds_read_b64 v[82:83], v60 offset:3072
s_waitcnt vmcnt(4)
v_readfirstlane_b32 s47, v124
s_waitcnt lgkmcnt(0)
v_pk_add_f32 v[76:77], v[76:77], v[78:79]
v_pk_add_f32 v[80:81], v[80:81], v[82:83]
v_pk_add_f32 v[24:25], v[76:77], v[80:81]
v_min_u32 v24, -2, v24
v_min_u32 v25, -2, v25
s_and_b32 s47, s47, 3
s_cmp_eq_u32 s47, 3
s_cbranch_scc1 L_last
global_store_dwordx4 v58, v[24:27], s[16:17] sc1
s_branch L_fin
L_reload:
global_load_dwordx4 v[104:107], v125, s[16:17] offset:0 sc1
global_load_dwordx4 v[108:111], v125, s[16:17] offset:1024 sc1
global_load_dwordx4 v[112:115], v125, s[16:17] offset:2048 sc1
global_load_dwordx4 v[116:119], v125, s[16:17] offset:3072 sc1
L_last:
s_waitcnt vmcnt(0)
s_cmp_lg_u32 s19, 0
s_cbranch_scc1 L_np0
v_mov_b32 v104, v24
v_mov_b32 v105, v25
v_mov_b32 v106, v26
L_np0:
s_cmp_lg_u32 s19, 1
s_cbranch_scc1 L_np1
v_mov_b32 v108, v24
v_mov_b32 v109, v25
v_mov_b32 v110, v26
L_np1:
s_cmp_lg_u32 s19, 2
s_cbranch_scc1 L_np2
v_mov_b32 v112, v24
v_mov_b32 v113, v25
v_mov_b32 v114, v26
L_np2:
s_cmp_lg_u32 s19, 3
s_cbranch_scc1 L_np3
v_mov_b32 v116, v24
v_mov_b32 v117, v25
v_mov_b32 v118, v26
L_np3:
v_max3_u32 v76, v104, v105, v106
v_max3_u32 v77, v108, v109, v110
v_max3_u32 v78, v112, v113, v114
v_max3_u32 v79, v116, v117, v118
v_max3_u32 v76, v76, v77, v78
v_max_u32 v76, v76, v79
v_cmp_eq_u32 vcc, -1, v76
v_add_f32 v80, v106, v110
v_add_f32 v82, v114, v118
s_cbranch_vccnz L_reload
v_add_f32 v80, v80, v82
v_add_f32 v80, s44, v80
v_rcp_f32 v80, v80
v_pk_add_f32 v[104:105], v[104:105], v[108:109]
v_pk_add_f32 v[112:113], v[112:113], v[116:117]
v_pk_add_f32 v[72:73], v[104:105], v[112:113]
L_write:
v_mul_f32 v72, v72, v80
v_mul_f32 v73, v73, v80
v_cvt_pk_bf16_f32 v72, v72, v73
global_store_dword v59, v72, s[12:13]
L_fin:
L_end:
s_endpgm
.section .rodata,"a"
.p2align 6
.amdhsa_kernel standalone__linear_kernel_rfa__decode_kernel
  .amdhsa_next_free_vgpr 128
  .amdhsa_next_free_sgpr 80
  .amdhsa_accum_offset 128
  .amdhsa_group_segment_fixed_size 0
  .amdhsa_kernarg_size 56
  .amdhsa_user_sgpr_count 2
  .amdhsa_user_sgpr_kernarg_segment_ptr 1
  .amdhsa_system_sgpr_workgroup_id_x 1
.end_amdhsa_kernel
```
